```python
import torch

def _softmax(x, axis=-1):
    return torch.softmax(x, dim=axis)
def _gelu(x):
    return torch.nn.functional.gelu(x, approximate="tanh")
def _silu(x):
    return torch.nn.functional.silu(x)
def _sigmoid(x):
    return torch.sigmoid(x)
def _layernorm(x, axis=-1, eps=1e-5):
    m = x.mean(dim=axis, keepdim=True)
    v = x.var(dim=axis, keepdim=True, unbiased=False)
    return (x - m) / torch.sqrt(v + eps)
def _scatter_add(tgt, idx, src, axis=0):
    return tgt.clone().index_add_(axis, idx, src)
def _segment_sum(src, seg, n):
    out = torch.zeros((n,) + src.shape[1:], dtype=src.dtype)
    return out.index_add_(0, seg, src)
def _pad(x, pw):
    flat = tuple(v for pair in reversed(pw) for v in pair)
    return torch.nn.functional.pad(x, flat)

kernel_name = 'standalone__consistency_rf_step__diffusion'

def setup_inputs():

    _w = (lambda a: (lambda t: t.to(torch.bfloat16) if t.is_floating_point() else t)(torch.as_tensor(a)))
    B, C, HW = 2, 320, 128
    return {
        "x": _w((lambda *s: torch.randn(*s, dtype=torch.bfloat16) * 0.05)(B, C, HW, HW)),
        "v": _w((lambda *s: torch.randn(*s, dtype=torch.bfloat16) * 0.05)(B, C, HW, HW)),
        "sigma": _w(torch.rand(B).to(float)),
    }

def reference(x, v, sigma):
    s = sigma.reshape(-1, 1, 1, 1)
    return x - s * v
```

```asm
; @launch grid=(256,1,1) block=(512,1,1) lds=0
.amdgcn_target "amdgcn-amd-amdhsa--gfx950"
.text
.globl standalone__consistency_rf_step__diffusion_kernel
.p2align 8
.type standalone__consistency_rf_step__diffusion_kernel,@function
standalone__consistency_rf_step__diffusion_kernel:
    s_load_dwordx2 s[4:5], s[0:1], 0
    s_load_dwordx2 s[8:9], s[0:1], 8
    s_load_dwordx2 s[16:17], s[0:1], 16
    s_load_dwordx2 s[12:13], s[0:1], 24
    s_cmp_ge_u32 s2, 256
    s_cbranch_scc1 L_end
    s_mov_b32 s6, 20971520
    s_mov_b32 s7, 0x00020000
    s_mov_b32 s10, 20971520
    s_mov_b32 s11, 0x00020000
    s_mov_b32 s14, 20971520
    s_mov_b32 s15, 0x00020000
    s_mov_b32 s20, 0xffff0000
    v_lshlrev_b32 v1, 4, v0
    s_mul_i32 s32, s2, 8192
    s_add_u32 s33, s32, 2097152
    s_add_u32 s34, s32, 4194304
    s_add_u32 s35, s32, 6291456
    s_add_u32 s36, s32, 8388608
    s_add_u32 s37, s32, 10485760
    s_add_u32 s38, s32, 12582912
    s_add_u32 s39, s32, 14680064
    s_add_u32 s40, s32, 16777216
    s_add_u32 s41, s32, 18874368
    s_waitcnt lgkmcnt(0)
    s_load_dword s18, s[16:17], 0
    buffer_load_dwordx4 v[4:7], v1, s[4:7], s32 offen
    buffer_load_dwordx4 v[8:11], v1, s[8:11], s32 offen
    buffer_load_dwordx4 v[12:15], v1, s[4:7], s33 offen
    buffer_load_dwordx4 v[16:19], v1, s[8:11], s33 offen
    s_waitcnt lgkmcnt(0)
    s_and_b32 s19, s18, s20
    s_lshl_b32 s18, s18, 16
    s_waitcnt vmcnt(2)
    buffer_load_dwordx4 v[20:23], v1, s[4:7], s34 offen
    buffer_load_dwordx4 v[24:27], v1, s[8:11], s34 offen
    v_lshlrev_b32 v28, 16, v8
    v_and_b32 v29, s20, v8
    v_lshlrev_b32 v30, 16, v9
    v_and_b32 v31, s20, v9
    v_lshlrev_b32 v32, 16, v10
    v_and_b32 v33, s20, v10
    v_lshlrev_b32 v34, 16, v11
    v_and_b32 v35, s20, v11
    v_pk_mul_f32 v[28:29], v[28:29], s[18:19] op_sel_hi:[1,0]
    v_pk_mul_f32 v[30:31], v[30:31], s[18:19] op_sel_hi:[1,0]
    v_pk_mul_f32 v[32:33], v[32:33], s[18:19] op_sel_hi:[1,0]
    v_pk_mul_f32 v[34:35], v[34:35], s[18:19] op_sel_hi:[1,0]
    v_cvt_pk_bf16_f32 v8, v28, v29
    v_cvt_pk_bf16_f32 v9, v30, v31
    v_cvt_pk_bf16_f32 v10, v32, v33
    v_cvt_pk_bf16_f32 v11, v34, v35
    v_lshlrev_b32 v28, 16, v4
    v_and_b32 v29, s20, v4
    v_lshlrev_b32 v30, 16, v5
    v_and_b32 v31, s20, v5
    v_lshlrev_b32 v32, 16, v6
    v_and_b32 v33, s20, v6
    v_lshlrev_b32 v34, 16, v7
    v_and_b32 v35, s20, v7
    v_lshlrev_b32 v36, 16, v8
    v_and_b32 v37, s20, v8
    v_pk_add_f32 v[28:29], v[28:29], v[36:37] neg_lo:[0,1] neg_hi:[0,1]
    v_lshlrev_b32 v38, 16, v9
    v_and_b32 v39, s20, v9
    v_pk_add_f32 v[30:31], v[30:31], v[38:39] neg_lo:[0,1] neg_hi:[0,1]
    v_lshlrev_b32 v36, 16, v10
    v_and_b32 v37, s20, v10
    v_pk_add_f32 v[32:33], v[32:33], v[36:37] neg_lo:[0,1] neg_hi:[0,1]
    v_lshlrev_b32 v38, 16, v11
    v_and_b32 v39, s20, v11
    v_pk_add_f32 v[34:35], v[34:35], v[38:39] neg_lo:[0,1] neg_hi:[0,1]
    v_cvt_pk_bf16_f32 v4, v28, v29
    v_cvt_pk_bf16_f32 v5, v30, v31
    v_cvt_pk_bf16_f32 v6, v32, v33
    v_cvt_pk_bf16_f32 v7, v34, v35
    buffer_store_dwordx4 v[4:7], v1, s[12:15], s32 offen
    s_waitcnt vmcnt(3)
    buffer_load_dwordx4 v[4:7], v1, s[4:7], s35 offen
    buffer_load_dwordx4 v[8:11], v1, s[8:11], s35 offen
    v_lshlrev_b32 v28, 16, v16
    v_and_b32 v29, s20, v16
    v_lshlrev_b32 v30, 16, v17
    v_and_b32 v31, s20, v17
    v_lshlrev_b32 v32, 16, v18
    v_and_b32 v33, s20, v18
    v_lshlrev_b32 v34, 16, v19
    v_and_b32 v35, s20, v19
    v_pk_mul_f32 v[28:29], v[28:29], s[18:19] op_sel_hi:[1,0]
    v_pk_mul_f32 v[30:31], v[30:31], s[18:19] op_sel_hi:[1,0]
    v_pk_mul_f32 v[32:33], v[32:33], s[18:19] op_sel_hi:[1,0]
    v_pk_mul_f32 v[34:35], v[34:35], s[18:19] op_sel_hi:[1,0]
    v_cvt_pk_bf16_f32 v16, v28, v29
    v_cvt_pk_bf16_f32 v17, v30, v31
    v_cvt_pk_bf16_f32 v18, v32, v33
    v_cvt_pk_bf16_f32 v19, v34, v35
    v_lshlrev_b32 v28, 16, v12
    v_and_b32 v29, s20, v12
    v_lshlrev_b32 v30, 16, v13
    v_and_b32 v31, s20, v13
    v_lshlrev_b32 v32, 16, v14
    v_and_b32 v33, s20, v14
    v_lshlrev_b32 v34, 16, v15
    v_and_b32 v35, s20, v15
    v_lshlrev_b32 v36, 16, v16
    v_and_b32 v37, s20, v16
    v_pk_add_f32 v[28:29], v[28:29], v[36:37] neg_lo:[0,1] neg_hi:[0,1]
    v_lshlrev_b32 v38, 16, v17
    v_and_b32 v39, s20, v17
    v_pk_add_f32 v[30:31], v[30:31], v[38:39] neg_lo:[0,1] neg_hi:[0,1]
    v_lshlrev_b32 v36, 16, v18
    v_and_b32 v37, s20, v18
    v_pk_add_f32 v[32:33], v[32:33], v[36:37] neg_lo:[0,1] neg_hi:[0,1]
    v_lshlrev_b32 v38, 16, v19
    v_and_b32 v39, s20, v19
    v_pk_add_f32 v[34:35], v[34:35], v[38:39] neg_lo:[0,1] neg_hi:[0,1]
    v_cvt_pk_bf16_f32 v12, v28, v29
    v_cvt_pk_bf16_f32 v13, v30, v31
    v_cvt_pk_bf16_f32 v14, v32, v33
    v_cvt_pk_bf16_f32 v15, v34, v35
    buffer_store_dwordx4 v[12:15], v1, s[12:15], s33 offen
    s_waitcnt vmcnt(4)
    buffer_load_dwordx4 v[12:15], v1, s[4:7], s36 offen
    buffer_load_dwordx4 v[16:19], v1, s[8:11], s36 offen
    v_lshlrev_b32 v28, 16, v24
    v_and_b32 v29, s20, v24
    v_lshlrev_b32 v30, 16, v25
    v_and_b32 v31, s20, v25
    v_lshlrev_b32 v32, 16, v26
    v_and_b32 v33, s20, v26
    v_lshlrev_b32 v34, 16, v27
    v_and_b32 v35, s20, v27
    v_pk_mul_f32 v[28:29], v[28:29], s[18:19] op_sel_hi:[1,0]
    v_pk_mul_f32 v[30:31], v[30:31], s[18:19] op_sel_hi:[1,0]
    v_pk_mul_f32 v[32:33], v[32:33], s[18:19] op_sel_hi:[1,0]
    v_pk_mul_f32 v[34:35], v[34:35], s[18:19] op_sel_hi:[1,0]
    v_cvt_pk_bf16_f32 v24, v28, v29
    v_cvt_pk_bf16_f32 v25, v30, v31
    v_cvt_pk_bf16_f32 v26, v32, v33
    v_cvt_pk_bf16_f32 v27, v34, v35
    v_lshlrev_b32 v28, 16, v20
    v_and_b32 v29, s20, v20
    v_lshlrev_b32 v30, 16, v21
    v_and_b32 v31, s20, v21
    v_lshlrev_b32 v32, 16, v22
    v_and_b32 v33, s20, v22
    v_lshlrev_b32 v34, 16, v23
    v_and_b32 v35, s20, v23
    v_lshlrev_b32 v36, 16, v24
    v_and_b32 v37, s20, v24
    v_pk_add_f32 v[28:29], v[28:29], v[36:37] neg_lo:[0,1] neg_hi:[0,1]
    v_lshlrev_b32 v38, 16, v25
    v_and_b32 v39, s20, v25
    v_pk_add_f32 v[30:31], v[30:31], v[38:39] neg_lo:[0,1] neg_hi:[0,1]
    v_lshlrev_b32 v36, 16, v26
    v_and_b32 v37, s20, v26
    v_pk_add_f32 v[32:33], v[32:33], v[36:37] neg_lo:[0,1] neg_hi:[0,1]
    v_lshlrev_b32 v38, 16, v27
    v_and_b32 v39, s20, v27
    v_pk_add_f32 v[34:35], v[34:35], v[38:39] neg_lo:[0,1] neg_hi:[0,1]
    v_cvt_pk_bf16_f32 v20, v28, v29
    v_cvt_pk_bf16_f32 v21, v30, v31
    v_cvt_pk_bf16_f32 v22, v32, v33
    v_cvt_pk_bf16_f32 v23, v34, v35
    buffer_store_dwordx4 v[20:23], v1, s[12:15], s34 offen
    s_waitcnt vmcnt(4)
    buffer_load_dwordx4 v[20:23], v1, s[4:7], s37 offen
    buffer_load_dwordx4 v[24:27], v1, s[8:11], s37 offen
    v_lshlrev_b32 v28, 16, v8
    v_and_b32 v29, s20, v8
    v_lshlrev_b32 v30, 16, v9
    v_and_b32 v31, s20, v9
    v_lshlrev_b32 v32, 16, v10
    v_and_b32 v33, s20, v10
    v_lshlrev_b32 v34, 16, v11
    v_and_b32 v35, s20, v11
    v_pk_mul_f32 v[28:29], v[28:29], s[18:19] op_sel_hi:[1,0]
    v_pk_mul_f32 v[30:31], v[30:31], s[18:19] op_sel_hi:[1,0]
    v_pk_mul_f32 v[32:33], v[32:33], s[18:19] op_sel_hi:[1,0]
    v_pk_mul_f32 v[34:35], v[34:35], s[18:19] op_sel_hi:[1,0]
    v_cvt_pk_bf16_f32 v8, v28, v29
    v_cvt_pk_bf16_f32 v9, v30, v31
    v_cvt_pk_bf16_f32 v10, v32, v33
    v_cvt_pk_bf16_f32 v11, v34, v35
    v_lshlrev_b32 v28, 16, v4
    v_and_b32 v29, s20, v4
    v_lshlrev_b32 v30, 16, v5
    v_and_b32 v31, s20, v5
    v_lshlrev_b32 v32, 16, v6
    v_and_b32 v33, s20, v6
    v_lshlrev_b32 v34, 16, v7
    v_and_b32 v35, s20, v7
    v_lshlrev_b32 v36, 16, v8
    v_and_b32 v37, s20, v8
    v_pk_add_f32 v[28:29], v[28:29], v[36:37] neg_lo:[0,1] neg_hi:[0,1]
    v_lshlrev_b32 v38, 16, v9
    v_and_b32 v39, s20, v9
    v_pk_add_f32 v[30:31], v[30:31], v[38:39] neg_lo:[0,1] neg_hi:[0,1]
    v_lshlrev_b32 v36, 16, v10
    v_and_b32 v37, s20, v10
    v_pk_add_f32 v[32:33], v[32:33], v[36:37] neg_lo:[0,1] neg_hi:[0,1]
    v_lshlrev_b32 v38, 16, v11
    v_and_b32 v39, s20, v11
    v_pk_add_f32 v[34:35], v[34:35], v[38:39] neg_lo:[0,1] neg_hi:[0,1]
    v_cvt_pk_bf16_f32 v4, v28, v29
    v_cvt_pk_bf16_f32 v5, v30, v31
    v_cvt_pk_bf16_f32 v6, v32, v33
    v_cvt_pk_bf16_f32 v7, v34, v35
    buffer_store_dwordx4 v[4:7], v1, s[12:15], s35 offen
    s_waitcnt vmcnt(4)
    buffer_load_dwordx4 v[4:7], v1, s[4:7], s38 offen
    buffer_load_dwordx4 v[8:11], v1, s[8:11], s38 offen
    v_lshlrev_b32 v28, 16, v16
    v_and_b32 v29, s20, v16
    v_lshlrev_b32 v30, 16, v17
    v_and_b32 v31, s20, v17
    v_lshlrev_b32 v32, 16, v18
    v_and_b32 v33, s20, v18
    v_lshlrev_b32 v34, 16, v19
    v_and_b32 v35, s20, v19
    v_pk_mul_f32 v[28:29], v[28:29], s[18:19] op_sel_hi:[1,0]
    v_pk_mul_f32 v[30:31], v[30:31], s[18:19] op_sel_hi:[1,0]
    v_pk_mul_f32 v[32:33], v[32:33], s[18:19] op_sel_hi:[1,0]
    v_pk_mul_f32 v[34:35], v[34:35], s[18:19] op_sel_hi:[1,0]
    v_cvt_pk_bf16_f32 v16, v28, v29
    v_cvt_pk_bf16_f32 v17, v30, v31
    v_cvt_pk_bf16_f32 v18, v32, v33
    v_cvt_pk_bf16_f32 v19, v34, v35
    v_lshlrev_b32 v28, 16, v12
    v_and_b32 v29, s20, v12
    v_lshlrev_b32 v30, 16, v13
    v_and_b32 v31, s20, v13
    v_lshlrev_b32 v32, 16, v14
    v_and_b32 v33, s20, v14
    v_lshlrev_b32 v34, 16, v15
    v_and_b32 v35, s20, v15
    v_lshlrev_b32 v36, 16, v16
    v_and_b32 v37, s20, v16
    v_pk_add_f32 v[28:29], v[28:29], v[36:37] neg_lo:[0,1] neg_hi:[0,1]
    v_lshlrev_b32 v38, 16, v17
    v_and_b32 v39, s20, v17
    v_pk_add_f32 v[30:31], v[30:31], v[38:39] neg_lo:[0,1] neg_hi:[0,1]
    v_lshlrev_b32 v36, 16, v18
    v_and_b32 v37, s20, v18
    v_pk_add_f32 v[32:33], v[32:33], v[36:37] neg_lo:[0,1] neg_hi:[0,1]
    v_lshlrev_b32 v38, 16, v19
    v_and_b32 v39, s20, v19
    v_pk_add_f32 v[34:35], v[34:35], v[38:39] neg_lo:[0,1] neg_hi:[0,1]
    v_cvt_pk_bf16_f32 v12, v28, v29
    v_cvt_pk_bf16_f32 v13, v30, v31
    v_cvt_pk_bf16_f32 v14, v32, v33
    v_cvt_pk_bf16_f32 v15, v34, v35
    buffer_store_dwordx4 v[12:15], v1, s[12:15], s36 offen
    s_waitcnt vmcnt(4)
    buffer_load_dwordx4 v[12:15], v1, s[4:7], s39 offen
    buffer_load_dwordx4 v[16:19], v1, s[8:11], s39 offen
    v_lshlrev_b32 v28, 16, v24
    v_and_b32 v29, s20, v24
    v_lshlrev_b32 v30, 16, v25
    v_and_b32 v31, s20, v25
    v_lshlrev_b32 v32, 16, v26
    v_and_b32 v33, s20, v26
    v_lshlrev_b32 v34, 16, v27
    v_and_b32 v35, s20, v27
    v_pk_mul_f32 v[28:29], v[28:29], s[18:19] op_sel:[0,1] op_sel_hi:[1,1]
    v_pk_mul_f32 v[30:31], v[30:31], s[18:19] op_sel:[0,1] op_sel_hi:[1,1]
    v_pk_mul_f32 v[32:33], v[32:33], s[18:19] op_sel:[0,1] op_sel_hi:[1,1]
    v_pk_mul_f32 v[34:35], v[34:35], s[18:19] op_sel:[0,1] op_sel_hi:[1,1]
    v_cvt_pk_bf16_f32 v24, v28, v29
    v_cvt_pk_bf16_f32 v25, v30, v31
    v_cvt_pk_bf16_f32 v26, v32, v33
    v_cvt_pk_bf16_f32 v27, v34, v35
    v_lshlrev_b32 v28, 16, v20
    v_and_b32 v29, s20, v20
    v_lshlrev_b32 v30, 16, v21
    v_and_b32 v31, s20, v21
    v_lshlrev_b32 v32, 16, v22
    v_and_b32 v33, s20, v22
    v_lshlrev_b32 v34, 16, v23
    v_and_b32 v35, s20, v23
    v_lshlrev_b32 v36, 16, v24
    v_and_b32 v37, s20, v24
    v_pk_add_f32 v[28:29], v[28:29], v[36:37] neg_lo:[0,1] neg_hi:[0,1]
    v_lshlrev_b32 v38, 16, v25
    v_and_b32 v39, s20, v25
    v_pk_add_f32 v[30:31], v[30:31], v[38:39] neg_lo:[0,1] neg_hi:[0,1]
    v_lshlrev_b32 v36, 16, v26
    v_and_b32 v37, s20, v26
    v_pk_add_f32 v[32:33], v[32:33], v[36:37] neg_lo:[0,1] neg_hi:[0,1]
    v_lshlrev_b32 v38, 16, v27
    v_and_b32 v39, s20, v27
    v_pk_add_f32 v[34:35], v[34:35], v[38:39] neg_lo:[0,1] neg_hi:[0,1]
    v_cvt_pk_bf16_f32 v20, v28, v29
    v_cvt_pk_bf16_f32 v21, v30, v31
    v_cvt_pk_bf16_f32 v22, v32, v33
    v_cvt_pk_bf16_f32 v23, v34, v35
    buffer_store_dwordx4 v[20:23], v1, s[12:15], s37 offen
    s_waitcnt vmcnt(4)
    buffer_load_dwordx4 v[20:23], v1, s[4:7], s40 offen
    buffer_load_dwordx4 v[24:27], v1, s[8:11], s40 offen
    v_lshlrev_b32 v28, 16, v8
    v_and_b32 v29, s20, v8
    v_lshlrev_b32 v30, 16, v9
    v_and_b32 v31, s20, v9
    v_lshlrev_b32 v32, 16, v10
    v_and_b32 v33, s20, v10
    v_lshlrev_b32 v34, 16, v11
    v_and_b32 v35, s20, v11
    v_pk_mul_f32 v[28:29], v[28:29], s[18:19] op_sel:[0,1] op_sel_hi:[1,1]
    v_pk_mul_f32 v[30:31], v[30:31], s[18:19] op_sel:[0,1] op_sel_hi:[1,1]
    v_pk_mul_f32 v[32:33], v[32:33], s[18:19] op_sel:[0,1] op_sel_hi:[1,1]
    v_pk_mul_f32 v[34:35], v[34:35], s[18:19] op_sel:[0,1] op_sel_hi:[1,1]
    v_cvt_pk_bf16_f32 v8, v28, v29
    v_cvt_pk_bf16_f32 v9, v30, v31
    v_cvt_pk_bf16_f32 v10, v32, v33
    v_cvt_pk_bf16_f32 v11, v34, v35
    v_lshlrev_b32 v28, 16, v4
    v_and_b32 v29, s20, v4
    v_lshlrev_b32 v30, 16, v5
    v_and_b32 v31, s20, v5
    v_lshlrev_b32 v32, 16, v6
    v_and_b32 v33, s20, v6
    v_lshlrev_b32 v34, 16, v7
    v_and_b32 v35, s20, v7
    v_lshlrev_b32 v36, 16, v8
    v_and_b32 v37, s20, v8
    v_pk_add_f32 v[28:29], v[28:29], v[36:37] neg_lo:[0,1] neg_hi:[0,1]
    v_lshlrev_b32 v38, 16, v9
    v_and_b32 v39, s20, v9
    v_pk_add_f32 v[30:31], v[30:31], v[38:39] neg_lo:[0,1] neg_hi:[0,1]
    v_lshlrev_b32 v36, 16, v10
    v_and_b32 v37, s20, v10
    v_pk_add_f32 v[32:33], v[32:33], v[36:37] neg_lo:[0,1] neg_hi:[0,1]
    v_lshlrev_b32 v38, 16, v11
    v_and_b32 v39, s20, v11
    v_pk_add_f32 v[34:35], v[34:35], v[38:39] neg_lo:[0,1] neg_hi:[0,1]
    v_cvt_pk_bf16_f32 v4, v28, v29
    v_cvt_pk_bf16_f32 v5, v30, v31
    v_cvt_pk_bf16_f32 v6, v32, v33
    v_cvt_pk_bf16_f32 v7, v34, v35
    buffer_store_dwordx4 v[4:7], v1, s[12:15], s38 offen
    s_waitcnt vmcnt(4)
    buffer_load_dwordx4 v[4:7], v1, s[4:7], s41 offen
    buffer_load_dwordx4 v[8:11], v1, s[8:11], s41 offen
    v_lshlrev_b32 v28, 16, v16
    v_and_b32 v29, s20, v16
    v_lshlrev_b32 v30, 16, v17
    v_and_b32 v31, s20, v17
    v_lshlrev_b32 v32, 16, v18
    v_and_b32 v33, s20, v18
    v_lshlrev_b32 v34, 16, v19
    v_and_b32 v35, s20, v19
    v_pk_mul_f32 v[28:29], v[28:29], s[18:19] op_sel:[0,1] op_sel_hi:[1,1]
    v_pk_mul_f32 v[30:31], v[30:31], s[18:19] op_sel:[0,1] op_sel_hi:[1,1]
    v_pk_mul_f32 v[32:33], v[32:33], s[18:19] op_sel:[0,1] op_sel_hi:[1,1]
    v_pk_mul_f32 v[34:35], v[34:35], s[18:19] op_sel:[0,1] op_sel_hi:[1,1]
    v_cvt_pk_bf16_f32 v16, v28, v29
    v_cvt_pk_bf16_f32 v17, v30, v31
    v_cvt_pk_bf16_f32 v18, v32, v33
    v_cvt_pk_bf16_f32 v19, v34, v35
    v_lshlrev_b32 v28, 16, v12
    v_and_b32 v29, s20, v12
    v_lshlrev_b32 v30, 16, v13
    v_and_b32 v31, s20, v13
    v_lshlrev_b32 v32, 16, v14
    v_and_b32 v33, s20, v14
    v_lshlrev_b32 v34, 16, v15
    v_and_b32 v35, s20, v15
    v_lshlrev_b32 v36, 16, v16
    v_and_b32 v37, s20, v16
    v_pk_add_f32 v[28:29], v[28:29], v[36:37] neg_lo:[0,1] neg_hi:[0,1]
    v_lshlrev_b32 v38, 16, v17
    v_and_b32 v39, s20, v17
    v_pk_add_f32 v[30:31], v[30:31], v[38:39] neg_lo:[0,1] neg_hi:[0,1]
    v_lshlrev_b32 v36, 16, v18
    v_and_b32 v37, s20, v18
    v_pk_add_f32 v[32:33], v[32:33], v[36:37] neg_lo:[0,1] neg_hi:[0,1]
    v_lshlrev_b32 v38, 16, v19
    v_and_b32 v39, s20, v19
    v_pk_add_f32 v[34:35], v[34:35], v[38:39] neg_lo:[0,1] neg_hi:[0,1]
    v_cvt_pk_bf16_f32 v12, v28, v29
    v_cvt_pk_bf16_f32 v13, v30, v31
    v_cvt_pk_bf16_f32 v14, v32, v33
    v_cvt_pk_bf16_f32 v15, v34, v35
    buffer_store_dwordx4 v[12:15], v1, s[12:15], s39 offen
    s_waitcnt vmcnt(4)
    v_lshlrev_b32 v28, 16, v24
    v_and_b32 v29, s20, v24
    v_lshlrev_b32 v30, 16, v25
    v_and_b32 v31, s20, v25
    v_lshlrev_b32 v32, 16, v26
    v_and_b32 v33, s20, v26
    v_lshlrev_b32 v34, 16, v27
    v_and_b32 v35, s20, v27
    v_pk_mul_f32 v[28:29], v[28:29], s[18:19] op_sel:[0,1] op_sel_hi:[1,1]
    v_pk_mul_f32 v[30:31], v[30:31], s[18:19] op_sel:[0,1] op_sel_hi:[1,1]
    v_pk_mul_f32 v[32:33], v[32:33], s[18:19] op_sel:[0,1] op_sel_hi:[1,1]
    v_pk_mul_f32 v[34:35], v[34:35], s[18:19] op_sel:[0,1] op_sel_hi:[1,1]
    v_cvt_pk_bf16_f32 v24, v28, v29
    v_cvt_pk_bf16_f32 v25, v30, v31
    v_cvt_pk_bf16_f32 v26, v32, v33
    v_cvt_pk_bf16_f32 v27, v34, v35
    v_lshlrev_b32 v28, 16, v20
    v_and_b32 v29, s20, v20
    v_lshlrev_b32 v30, 16, v21
    v_and_b32 v31, s20, v21
    v_lshlrev_b32 v32, 16, v22
    v_and_b32 v33, s20, v22
    v_lshlrev_b32 v34, 16, v23
    v_and_b32 v35, s20, v23
    v_lshlrev_b32 v36, 16, v24
    v_and_b32 v37, s20, v24
    v_pk_add_f32 v[28:29], v[28:29], v[36:37] neg_lo:[0,1] neg_hi:[0,1]
    v_lshlrev_b32 v38, 16, v25
    v_and_b32 v39, s20, v25
    v_pk_add_f32 v[30:31], v[30:31], v[38:39] neg_lo:[0,1] neg_hi:[0,1]
    v_lshlrev_b32 v36, 16, v26
    v_and_b32 v37, s20, v26
    v_pk_add_f32 v[32:33], v[32:33], v[36:37] neg_lo:[0,1] neg_hi:[0,1]
    v_lshlrev_b32 v38, 16, v27
    v_and_b32 v39, s20, v27
    v_pk_add_f32 v[34:35], v[34:35], v[38:39] neg_lo:[0,1] neg_hi:[0,1]
    v_cvt_pk_bf16_f32 v20, v28, v29
    v_cvt_pk_bf16_f32 v21, v30, v31
    v_cvt_pk_bf16_f32 v22, v32, v33
    v_cvt_pk_bf16_f32 v23, v34, v35
    buffer_store_dwordx4 v[20:23], v1, s[12:15], s40 offen
    s_waitcnt vmcnt(2)
    v_lshlrev_b32 v28, 16, v8
    v_and_b32 v29, s20, v8
    v_lshlrev_b32 v30, 16, v9
    v_and_b32 v31, s20, v9
    v_lshlrev_b32 v32, 16, v10
    v_and_b32 v33, s20, v10
    v_lshlrev_b32 v34, 16, v11
    v_and_b32 v35, s20, v11
    v_pk_mul_f32 v[28:29], v[28:29], s[18:19] op_sel:[0,1] op_sel_hi:[1,1]
    v_pk_mul_f32 v[30:31], v[30:31], s[18:19] op_sel:[0,1] op_sel_hi:[1,1]
    v_pk_mul_f32 v[32:33], v[32:33], s[18:19] op_sel:[0,1] op_sel_hi:[1,1]
    v_pk_mul_f32 v[34:35], v[34:35], s[18:19] op_sel:[0,1] op_sel_hi:[1,1]
    v_cvt_pk_bf16_f32 v8, v28, v29
    v_cvt_pk_bf16_f32 v9, v30, v31
    v_cvt_pk_bf16_f32 v10, v32, v33
    v_cvt_pk_bf16_f32 v11, v34, v35
    v_lshlrev_b32 v28, 16, v4
    v_and_b32 v29, s20, v4
    v_lshlrev_b32 v30, 16, v5
    v_and_b32 v31, s20, v5
    v_lshlrev_b32 v32, 16, v6
    v_and_b32 v33, s20, v6
    v_lshlrev_b32 v34, 16, v7
    v_and_b32 v35, s20, v7
    v_lshlrev_b32 v36, 16, v8
    v_and_b32 v37, s20, v8
    v_pk_add_f32 v[28:29], v[28:29], v[36:37] neg_lo:[0,1] neg_hi:[0,1]
    v_lshlrev_b32 v38, 16, v9
    v_and_b32 v39, s20, v9
    v_pk_add_f32 v[30:31], v[30:31], v[38:39] neg_lo:[0,1] neg_hi:[0,1]
    v_lshlrev_b32 v36, 16, v10
    v_and_b32 v37, s20, v10
    v_pk_add_f32 v[32:33], v[32:33], v[36:37] neg_lo:[0,1] neg_hi:[0,1]
    v_lshlrev_b32 v38, 16, v11
    v_and_b32 v39, s20, v11
    v_pk_add_f32 v[34:35], v[34:35], v[38:39] neg_lo:[0,1] neg_hi:[0,1]
    v_cvt_pk_bf16_f32 v4, v28, v29
    v_cvt_pk_bf16_f32 v5, v30, v31
    v_cvt_pk_bf16_f32 v6, v32, v33
    v_cvt_pk_bf16_f32 v7, v34, v35
    buffer_store_dwordx4 v[4:7], v1, s[12:15], s41 offen
L_end:
    s_endpgm
.section .rodata,"a"
.p2align 6
.amdhsa_kernel standalone__consistency_rf_step__diffusion_kernel
  .amdhsa_next_free_vgpr 40
  .amdhsa_next_free_sgpr 43
  .amdhsa_accum_offset 40
  .amdhsa_group_segment_fixed_size 0
  .amdhsa_kernarg_size 48
  .amdhsa_user_sgpr_count 2
  .amdhsa_user_sgpr_kernarg_segment_ptr 1
  .amdhsa_system_sgpr_workgroup_id_x 1
  .amdhsa_float_denorm_mode_32 3
  .amdhsa_float_denorm_mode_16_64 3
.end_amdhsa_kernel
```
